```python
import torch

def _softmax(x, axis=-1):
    return torch.softmax(x, dim=axis)
def _gelu(x):
    return torch.nn.functional.gelu(x, approximate="tanh")
def _silu(x):
    return torch.nn.functional.silu(x)
def _sigmoid(x):
    return torch.sigmoid(x)
def _layernorm(x, axis=-1, eps=1e-5):
    m = x.mean(dim=axis, keepdim=True)
    v = x.var(dim=axis, keepdim=True, unbiased=False)
    return (x - m) / torch.sqrt(v + eps)
def _scatter_add(tgt, idx, src, axis=0):
    return tgt.clone().index_add_(axis, idx, src)
def _segment_sum(src, seg, n):
    out = torch.zeros((n,) + src.shape[1:], dtype=src.dtype)
    return out.index_add_(0, seg, src)
def _pad(x, pw):
    flat = tuple(v for pair in reversed(pw) for v in pair)
    return torch.nn.functional.pad(x, flat)

kernel_name = 'standalone__paged_block_table_kv_radixattention__sampling'

def setup_inputs():

    _w = (lambda a: (lambda t: t.to(torch.bfloat16) if t.is_floating_point() else t)(torch.as_tensor(a)))
    B, H, Hkv, Dh = 8, 32, 8, 128
    Lk = 2048
    bs = 16
    nb = max(2, Lk // bs)
    P = max(1, nb // 2)
    n_phys = P + B * (nb - P)
    shared = torch.arange(P, dtype=torch.int64)
    priv = P + torch.arange(B * (nb - P), dtype=torch.int64).reshape(B, nb - P)
    bt = torch.cat([torch.tile(shared[None, :], (B, 1)), priv], dim=1)
    ctx = nb * bs - (torch.arange(1, B + 1, dtype=torch.int64) * 2654435761) % max(1, (nb * bs - P * bs) // 2)
    return {
        "q": _w((lambda *s: torch.randn(*s, dtype=torch.bfloat16) * 0.8)(B, H, Dh)),
        "k_cache": _w((lambda *s: torch.randn(*s, dtype=torch.bfloat16) * 0.8)(n_phys, bs, Hkv, Dh)),
        "v_cache": _w((lambda *s: torch.randn(*s, dtype=torch.bfloat16) * 0.05)(n_phys, bs, Hkv, Dh)),
        "block_table": _w(bt.to(torch.int64)),
        "ctx_lens": _w(torch.as_tensor(ctx).to(torch.int64)),
    }

def reference(q, k_cache, v_cache, block_table, ctx_lens):
    B, H, Dh = q.shape
    n_phys, bs, Hkv, _ = k_cache.shape
    nb = block_table.shape[1]
    Lk = nb * bs
    rep = H // Hkv
    k = k_cache[block_table].reshape(B, Lk, Hkv, Dh)
    v = v_cache[block_table].reshape(B, Lk, Hkv, Dh)
    k = (lambda x, n, axis: torch.repeat_interleave(x, n, dim=axis))(k, rep, axis=2)
    v = (lambda x, n, axis: torch.repeat_interleave(x, n, dim=axis))(v, rep, axis=2)
    scores = torch.einsum("bhd,bkhd->bhk", q, k) * (Dh ** -0.5)
    pos = torch.arange(Lk)
    valid = pos[None, :] < ctx_lens[:, None]
    scores = torch.where(valid[:, None, :], scores, -1e9)
    p = _softmax(scores, axis=-1)
    return torch.einsum("bhk,bkhd->bhd", p, v)
```

```asm
; @launch grid=(512,1,1) block=(512,1,1) lds=16640
.amdgcn_target "amdgcn-amd-amdhsa--gfx950"
.text
.globl standalone__paged_block_table_kv_radixattention__sampling_kernel
.p2align 8
.type standalone__paged_block_table_kv_radixattention__sampling_kernel,@function
standalone__paged_block_table_kv_radixattention__sampling_kernel:

    s_cmp_ge_u32 s2, 512
    s_cbranch_scc1 L1_end
    s_load_dwordx16 s[4:19], s[0:1], 0
    v_lshrrev_b32 v1, 6, v0
    v_and_b32 v2, 15, v0
    v_readfirstlane_b32 s40, v1
    v_bfe_u32 v3, v0, 4, 2

    s_and_b32 s38, s2, 7
    s_bfe_u32 s36, s2, 0x30003
    s_lshr_b32 s39, s2, 6
    s_lshl_b32 s62, s40, 3
    s_add_u32 s62, s62, s38

    s_lshl_b32 s41, s39, 2
    s_lshl_b32 s43, s39, 9
    s_lshl_b32 s46, s62, 3
    s_add_u32 s43, s43, s46
    s_waitcnt lgkmcnt(0)
    s_load_dword s42, s[12:13], s41
    s_load_dwordx2 s[44:45], s[10:11], s43
    s_mov_b32 s20, s6
    s_and_b32 s21, s7, 0xffff
    s_mov_b32 s22, 18874368
    s_mov_b32 s23, 0x00020000
    s_mov_b32 s24, s8
    s_and_b32 s25, s9, 0xffff
    s_mov_b32 s26, 18874368
    s_mov_b32 s27, 0x00020000
    s_mov_b32 s28, s4
    s_and_b32 s29, s5, 0xffff
    s_mov_b32 s30, 65536
    s_mov_b32 s31, 0x00020000
    s_mov_b32 s32, s18
    s_and_b32 s33, s19, 0xffff
    s_mov_b32 s34, 0x800000
    s_mov_b32 s35, 0x00020000
    v_lshrrev_b32 v8, 2, v2
    v_and_b32 v9, 3, v2
    v_lshl_add_u32 v10, v3, 2, v9
    v_lshlrev_b32 v10, 4, v10
    v_lshl_add_u32 v4, v8, 11, v10
    v_add_u32 v11, 0x2000, v4
    v_add_u32 v12, 0x4000, v4
    v_add_u32 v13, 0x6000, v4
    v_lshl_add_u32 v7, v8, 8, v10
    v_lshlrev_b32 v5, 11, v3
    v_lshl_add_u32 v5, v2, 4, v5
    v_add_u32 v14, 0x2000, v5
    v_add_u32 v15, 0x4000, v5
    v_add_u32 v16, 0x6000, v5
    s_lshl_b32 s48, s62, 5
    s_lshl_b32 s49, s36, 8
    s_lshl_b32 s50, s39, 13
    s_lshl_b32 s51, s36, 10
    s_add_u32 s50, s50, s51
    s_mov_b32 s52, 0x05040100
    s_mov_b32 s53, 0x07060302
    s_mov_b32 s54, 0x3e0293ee
    buffer_load_dwordx4 v[20:23], v7, s[28:31], s50 offen
    s_waitcnt lgkmcnt(0)
    s_cmp_ge_u32 s48, s42
    s_cbranch_scc1 L1_empty
    s_lshl_b32 s44, s44, 15
    s_lshl_b32 s45, s45, 15
    s_add_u32 s44, s44, s49
    s_add_u32 s45, s45, s49

    buffer_load_dwordx4 v[24:27], v4, s[20:23], s44 offen
    buffer_load_dwordx4 v[28:31], v11, s[20:23], s44 offen
    buffer_load_dwordx4 v[32:35], v12, s[20:23], s44 offen
    buffer_load_dwordx4 v[36:39], v13, s[20:23], s44 offen
    buffer_load_dwordx4 v[40:43], v4, s[20:23], s45 offen
    buffer_load_dwordx4 v[44:47], v11, s[20:23], s45 offen
    buffer_load_dwordx4 v[48:51], v12, s[20:23], s45 offen
    buffer_load_dwordx4 v[52:55], v13, s[20:23], s45 offen
    buffer_load_dwordx4 v[56:59], v5, s[24:27], s44 offen
    buffer_load_dwordx4 v[60:63], v14, s[24:27], s44 offen
    buffer_load_dwordx4 v[64:67], v15, s[24:27], s44 offen
    buffer_load_dwordx4 v[68:71], v16, s[24:27], s44 offen
    buffer_load_dwordx4 v[72:75], v5, s[24:27], s45 offen
    buffer_load_dwordx4 v[76:79], v14, s[24:27], s45 offen
    buffer_load_dwordx4 v[80:83], v15, s[24:27], s45 offen
    buffer_load_dwordx4 v[84:87], v16, s[24:27], s45 offen
    v_cmp_eq_u32 s[64:65], 0, v9
    v_cmp_eq_u32 s[66:67], 1, v9
    v_cmp_eq_u32 s[68:69], 2, v9
    v_add_u32 v1, s48, v3
    v_mov_b32 v17, 0xf149f2ca
    s_waitcnt vmcnt(8)
    v_mfma_f32_16x16x32_bf16 v[96:99], v[24:27], v[20:23], 0
    v_mfma_f32_16x16x32_bf16 v[100:103], v[28:31], v[20:23], 0
    v_mfma_f32_16x16x32_bf16 v[104:107], v[32:35], v[20:23], 0
    v_mfma_f32_16x16x32_bf16 v[108:111], v[36:39], v[20:23], 0
    v_mfma_f32_16x16x32_bf16 v[112:115], v[40:43], v[20:23], 0
    v_mfma_f32_16x16x32_bf16 v[116:119], v[44:47], v[20:23], 0
    v_mfma_f32_16x16x32_bf16 v[120:123], v[48:51], v[20:23], 0
    v_mfma_f32_16x16x32_bf16 v[124:127], v[52:55], v[20:23], 0
    s_nop 7
    v_cndmask_b32 v88, v99, v98, s[68:69]
    v_cndmask_b32 v88, v88, v97, s[66:67]
    v_cndmask_b32 v88, v88, v96, s[64:65]
    v_cndmask_b32 v89, v103, v102, s[68:69]
    v_cndmask_b32 v89, v89, v101, s[66:67]
    v_cndmask_b32 v89, v89, v100, s[64:65]
    v_cndmask_b32 v90, v107, v106, s[68:69]
    v_cndmask_b32 v90, v90, v105, s[66:67]
    v_cndmask_b32 v90, v90, v104, s[64:65]
    v_cndmask_b32 v91, v111, v110, s[68:69]
    v_cndmask_b32 v91, v91, v109, s[66:67]
    v_cndmask_b32 v91, v91, v108, s[64:65]
    v_cndmask_b32 v92, v115, v114, s[68:69]
    v_cndmask_b32 v92, v92, v113, s[66:67]
    v_cndmask_b32 v92, v92, v112, s[64:65]
    v_cndmask_b32 v93, v119, v118, s[68:69]
    v_cndmask_b32 v93, v93, v117, s[66:67]
    v_cndmask_b32 v93, v93, v116, s[64:65]
    v_cndmask_b32 v94, v123, v122, s[68:69]
    v_cndmask_b32 v94, v94, v121, s[66:67]
    v_cndmask_b32 v94, v94, v120, s[64:65]
    v_cndmask_b32 v95, v127, v126, s[68:69]
    v_cndmask_b32 v95, v95, v125, s[66:67]
    v_cndmask_b32 v95, v95, v124, s[64:65]
    s_nop 1
    v_add_f32_dpp v88, v88, v88 quad_perm:[1,0,3,2] row_mask:0xf bank_mask:0xf
    v_add_f32_dpp v89, v89, v89 quad_perm:[1,0,3,2] row_mask:0xf bank_mask:0xf
    v_add_f32_dpp v90, v90, v90 quad_perm:[1,0,3,2] row_mask:0xf bank_mask:0xf
    v_add_f32_dpp v91, v91, v91 quad_perm:[1,0,3,2] row_mask:0xf bank_mask:0xf
    v_add_f32_dpp v92, v92, v92 quad_perm:[1,0,3,2] row_mask:0xf bank_mask:0xf
    v_add_f32_dpp v93, v93, v93 quad_perm:[1,0,3,2] row_mask:0xf bank_mask:0xf
    v_add_f32_dpp v94, v94, v94 quad_perm:[1,0,3,2] row_mask:0xf bank_mask:0xf
    v_add_f32_dpp v95, v95, v95 quad_perm:[1,0,3,2] row_mask:0xf bank_mask:0xf
    s_nop 1
    v_add_f32_dpp v88, v88, v88 quad_perm:[2,3,0,1] row_mask:0xf bank_mask:0xf
    v_add_f32_dpp v89, v89, v89 quad_perm:[2,3,0,1] row_mask:0xf bank_mask:0xf
    v_add_f32_dpp v90, v90, v90 quad_perm:[2,3,0,1] row_mask:0xf bank_mask:0xf
    v_add_f32_dpp v91, v91, v91 quad_perm:[2,3,0,1] row_mask:0xf bank_mask:0xf
    v_add_f32_dpp v92, v92, v92 quad_perm:[2,3,0,1] row_mask:0xf bank_mask:0xf
    v_add_f32_dpp v93, v93, v93 quad_perm:[2,3,0,1] row_mask:0xf bank_mask:0xf
    v_add_f32_dpp v94, v94, v94 quad_perm:[2,3,0,1] row_mask:0xf bank_mask:0xf
    v_add_f32_dpp v95, v95, v95 quad_perm:[2,3,0,1] row_mask:0xf bank_mask:0xf
    v_mul_f32 v88, s54, v88
    v_add_u32 v18, 0, v1
    v_cmp_gt_u32 vcc, s42, v18
    s_nop 1
    v_cndmask_b32 v88, v17, v88, vcc
    v_mul_f32 v89, s54, v89
    v_add_u32 v18, 4, v1
    v_cmp_gt_u32 vcc, s42, v18
    s_nop 1
    v_cndmask_b32 v89, v17, v89, vcc
    v_mul_f32 v90, s54, v90
    v_add_u32 v18, 8, v1
    v_cmp_gt_u32 vcc, s42, v18
    s_nop 1
    v_cndmask_b32 v90, v17, v90, vcc
    v_mul_f32 v91, s54, v91
    v_add_u32 v18, 12, v1
    v_cmp_gt_u32 vcc, s42, v18
    s_nop 1
    v_cndmask_b32 v91, v17, v91, vcc
    v_mul_f32 v92, s54, v92
    v_add_u32 v18, 16, v1
    v_cmp_gt_u32 vcc, s42, v18
    s_nop 1
    v_cndmask_b32 v92, v17, v92, vcc
    v_mul_f32 v93, s54, v93
    v_add_u32 v18, 20, v1
    v_cmp_gt_u32 vcc, s42, v18
    s_nop 1
    v_cndmask_b32 v93, v17, v93, vcc
    v_mul_f32 v94, s54, v94
    v_add_u32 v18, 24, v1
    v_cmp_gt_u32 vcc, s42, v18
    s_nop 1
    v_cndmask_b32 v94, v17, v94, vcc
    v_mul_f32 v95, s54, v95
    v_add_u32 v18, 28, v1
    v_cmp_gt_u32 vcc, s42, v18
    s_nop 1
    v_cndmask_b32 v95, v17, v95, vcc
    v_max3_f32 v18, v88, v89, v90
    v_max3_f32 v18, v18, v91, v92
    v_max3_f32 v18, v18, v93, v94
    v_max_f32 v18, v18, v95
    v_mov_b32 v17, v18
    s_nop 1
    v_permlane16_swap_b32 v18, v17
    v_max_f32 v18, v18, v17
    v_mov_b32 v17, v18
    s_nop 1
    v_permlane32_swap_b32 v18, v17
    v_max_f32 v18, v18, v17
    v_sub_f32 v88, v88, v18
    v_sub_f32 v89, v89, v18
    v_sub_f32 v90, v90, v18
    v_sub_f32 v91, v91, v18
    v_sub_f32 v92, v92, v18
    v_sub_f32 v93, v93, v18
    v_sub_f32 v94, v94, v18
    v_sub_f32 v95, v95, v18
    v_exp_f32 v88, v88
    v_exp_f32 v89, v89
    v_exp_f32 v90, v90
    v_exp_f32 v91, v91
    v_exp_f32 v92, v92
    v_exp_f32 v93, v93
    v_exp_f32 v94, v94
    v_exp_f32 v95, v95
    s_nop 0
    v_add_f32 v19, v88, v89
    v_add_f32 v19, v19, v90
    v_add_f32 v19, v19, v91
    v_add_f32 v19, v19, v92
    v_add_f32 v19, v19, v93
    v_add_f32 v19, v19, v94
    v_add_f32 v19, v19, v95
    v_mov_b32 v17, v19
    s_nop 1
    v_permlane16_swap_b32 v19, v17
    v_add_f32 v19, v19, v17
    v_mov_b32 v17, v19
    s_nop 1
    v_permlane32_swap_b32 v19, v17
    v_add_f32 v19, v19, v17
    v_cvt_pk_bf16_f32 v20, v88, v89
    v_cvt_pk_bf16_f32 v21, v90, v91
    v_cvt_pk_bf16_f32 v22, v92, v93
    v_cvt_pk_bf16_f32 v23, v94, v95
    s_waitcnt vmcnt(0)
    v_perm_b32 v24, v60, v56, s52
    v_perm_b32 v25, v68, v64, s52
    v_perm_b32 v26, v76, v72, s52
    v_perm_b32 v27, v84, v80, s52
    v_perm_b32 v28, v60, v56, s53
    v_perm_b32 v29, v68, v64, s53
    v_perm_b32 v30, v76, v72, s53
    v_perm_b32 v31, v84, v80, s53
    v_perm_b32 v32, v61, v57, s52
    v_perm_b32 v33, v69, v65, s52
    v_perm_b32 v34, v77, v73, s52
    v_perm_b32 v35, v85, v81, s52
    v_perm_b32 v36, v61, v57, s53
    v_perm_b32 v37, v69, v65, s53
    v_perm_b32 v38, v77, v73, s53
    v_perm_b32 v39, v85, v81, s53
    v_perm_b32 v40, v62, v58, s52
    v_perm_b32 v41, v70, v66, s52
    v_perm_b32 v42, v78, v74, s52
    v_perm_b32 v43, v86, v82, s52
    v_perm_b32 v44, v62, v58, s53
    v_perm_b32 v45, v70, v66, s53
    v_perm_b32 v46, v78, v74, s53
    v_perm_b32 v47, v86, v82, s53
    v_perm_b32 v48, v63, v59, s52
    v_perm_b32 v49, v71, v67, s52
    v_perm_b32 v50, v79, v75, s52
    v_perm_b32 v51, v87, v83, s52
    v_perm_b32 v52, v63, v59, s53
    v_perm_b32 v53, v71, v67, s53
    v_perm_b32 v54, v79, v75, s53
    v_perm_b32 v55, v87, v83, s53
    s_nop 1
    v_mfma_f32_16x16x32_bf16 v[96:99], v[20:23], v[24:27], 0
    v_mfma_f32_16x16x32_bf16 v[100:103], v[20:23], v[28:31], 0
    v_mfma_f32_16x16x32_bf16 v[104:107], v[20:23], v[32:35], 0
    v_mfma_f32_16x16x32_bf16 v[108:111], v[20:23], v[36:39], 0
    v_mfma_f32_16x16x32_bf16 v[112:115], v[20:23], v[40:43], 0
    v_mfma_f32_16x16x32_bf16 v[116:119], v[20:23], v[44:47], 0
    v_mfma_f32_16x16x32_bf16 v[120:123], v[20:23], v[48:51], 0
    v_mfma_f32_16x16x32_bf16 v[124:127], v[20:23], v[52:55], 0
    s_nop 7
    v_mov_b32 v88, v96
    v_mov_b32 v89, v100
    v_mov_b32 v90, v104
    v_mov_b32 v91, v108
    v_mov_b32 v92, v112
    v_mov_b32 v93, v116
    v_mov_b32 v94, v120
    v_mov_b32 v95, v124
    s_branch L1_join
L1_empty:
    s_waitcnt vmcnt(0)
    v_mov_b32 v18, 0xf149f2ca
    v_mov_b32 v19, 0
    v_mov_b32 v88, 0
    v_mov_b32 v89, 0
    v_mov_b32 v90, 0
    v_mov_b32 v91, 0
    v_mov_b32 v92, 0
    v_mov_b32 v93, 0
    v_mov_b32 v94, 0
    v_mov_b32 v95, 0
L1_join:

    s_lshl_b32 s55, s40, 11
    v_and_b32 v1, 63, v0
    v_lshlrev_b32 v1, 5, v1
    v_add_u32 v1, s55, v1
    s_lshl_b32 s55, s40, 5
    v_lshlrev_b32 v17, 1, v2
    v_add_u32 v17, s55, v17
    ds_write_b128 v1, v[88:91]
    ds_write_b128 v1, v[92:95] offset:16
    s_mov_b64 exec, 0x1111
    ds_write_b64 v17, v[18:19] offset:16384
    s_mov_b64 exec, -1
    s_waitcnt lgkmcnt(0)
    s_barrier
    s_cmp_ge_u32 s40, 4
    s_cbranch_scc1 L1_end
    v_lshlrev_b32 v1, 3, v0
    v_lshrrev_b32 v2, 6, v0
    v_lshlrev_b32 v2, 3, v2

    ds_read_b64 v[48:49], v2 offset:16384
    ds_read_b64 v[50:51], v2 offset:16416
    ds_read_b64 v[52:53], v2 offset:16448
    ds_read_b64 v[54:55], v2 offset:16480
    ds_read_b64 v[56:57], v2 offset:16512
    ds_read_b64 v[58:59], v2 offset:16544
    ds_read_b64 v[60:61], v2 offset:16576
    ds_read_b64 v[62:63], v2 offset:16608
    ds_read_b64 v[16:17], v1 offset:0
    ds_read_b64 v[18:19], v1 offset:2048
    ds_read_b64 v[20:21], v1 offset:4096
    ds_read_b64 v[22:23], v1 offset:6144
    ds_read_b64 v[24:25], v1 offset:8192
    ds_read_b64 v[26:27], v1 offset:10240
    ds_read_b64 v[28:29], v1 offset:12288
    ds_read_b64 v[30:31], v1 offset:14336
    s_waitcnt lgkmcnt(8)
    v_max_f32 v84, v48, v50
    v_max_f32 v84, v84, v52
    v_max_f32 v84, v84, v54
    v_max_f32 v84, v84, v56
    v_max_f32 v84, v84, v58
    v_max_f32 v84, v84, v60
    v_max_f32 v84, v84, v62
    v_sub_f32 v48, v48, v84
    v_sub_f32 v50, v50, v84
    v_sub_f32 v52, v52, v84
    v_sub_f32 v54, v54, v84
    v_sub_f32 v56, v56, v84
    v_sub_f32 v58, v58, v84
    v_sub_f32 v60, v60, v84
    v_sub_f32 v62, v62, v84
    v_exp_f32 v48, v48
    v_exp_f32 v50, v50
    v_exp_f32 v52, v52
    v_exp_f32 v54, v54
    v_exp_f32 v56, v56
    v_exp_f32 v58, v58
    v_exp_f32 v60, v60
    v_exp_f32 v62, v62
    s_waitcnt lgkmcnt(0)
    v_mul_f32 v85, v48, v49
    v_mul_f32 v86, v48, v16
    v_mul_f32 v87, v48, v17
    v_fmac_f32 v85, v50, v51
    v_fmac_f32 v86, v50, v18
    v_fmac_f32 v87, v50, v19
    v_fmac_f32 v85, v52, v53
    v_fmac_f32 v86, v52, v20
    v_fmac_f32 v87, v52, v21
    v_fmac_f32 v85, v54, v55
    v_fmac_f32 v86, v54, v22
    v_fmac_f32 v87, v54, v23
    v_fmac_f32 v85, v56, v57
    v_fmac_f32 v86, v56, v24
    v_fmac_f32 v87, v56, v25
    v_fmac_f32 v85, v58, v59
    v_fmac_f32 v86, v58, v26
    v_fmac_f32 v87, v58, v27
    v_fmac_f32 v85, v60, v61
    v_fmac_f32 v86, v60, v28
    v_fmac_f32 v87, v60, v29
    v_fmac_f32 v85, v62, v63
    v_fmac_f32 v86, v62, v30
    v_fmac_f32 v87, v62, v31

    s_lshl_b32 s58, s39, 3
    s_add_u32 s58, s58, s36
    s_lshl_b32 s55, s58, 3
    s_add_u32 s55, s55, s38
    s_lshl_b32 s56, s55, 11
    s_lshl_b32 s57, s55, 5
    s_add_u32 s57, s57, 4194304
    buffer_store_dwordx2 v[86:87], v1, s[32:35], s56 offen sc0 sc1
    s_mov_b64 exec, 1
    buffer_store_dwordx2 v[84:85], v2, s[32:35], s57 offen sc0 sc1
    s_mov_b64 exec, -1
    s_waitcnt vmcnt(0)
    s_barrier
    s_cmp_lg_u32 s40, 0
    s_cbranch_scc1 L1_wait_ticket
    s_lshl_b32 s59, s58, 2
    v_mov_b32 v3, s59
    v_mov_b32 v4, 1
    s_mov_b64 exec, 1
    global_atomic_add v5, v3, v4, s[16:17] sc0 sc1
    s_waitcnt vmcnt(0)
    v_mov_b32 v6, 0
    ds_write_b32 v6, v5
    s_mov_b64 exec, -1
    s_waitcnt lgkmcnt(0)
L1_wait_ticket:
    s_barrier
    v_mov_b32 v6, 0
    ds_read_b32 v5, v6
    s_waitcnt lgkmcnt(0)
    v_readfirstlane_b32 s59, v5
    s_cmp_lg_u32 s59, 7
    s_cbranch_scc1 L1_end
    s_mov_b32 s28, s14
    s_and_b32 s29, s15, 0xffff
    s_mov_b32 s30, 65536
    s_mov_b32 s31, 0x00020000
    v_and_b32 v2, 63, v0
    v_lshlrev_b32 v11, 2, v2
    v_lshlrev_b32 v2, 3, v2
    s_lshl_b32 s56, s58, 14
    s_lshl_b32 s41, s40, 9
    s_add_u32 s56, s56, s41
    s_lshl_b32 s57, s58, 8
    s_lshl_b32 s41, s40, 3
    s_add_u32 s57, s57, s41
    s_add_u32 s57, s57, 4194304
    v_mov_b32 v3, 0

    buffer_load_dwordx2 v[48:49], v3, s[32:35], s57 offen offset:0 sc0 sc1
    buffer_load_dwordx2 v[50:51], v3, s[32:35], s57 offen offset:32 sc0 sc1
    buffer_load_dwordx2 v[52:53], v3, s[32:35], s57 offen offset:64 sc0 sc1
    buffer_load_dwordx2 v[54:55], v3, s[32:35], s57 offen offset:96 sc0 sc1
    buffer_load_dwordx2 v[56:57], v3, s[32:35], s57 offen offset:128 sc0 sc1
    buffer_load_dwordx2 v[58:59], v3, s[32:35], s57 offen offset:160 sc0 sc1
    buffer_load_dwordx2 v[60:61], v3, s[32:35], s57 offen offset:192 sc0 sc1
    buffer_load_dwordx2 v[62:63], v3, s[32:35], s57 offen offset:224 sc0 sc1
    buffer_load_dwordx2 v[16:17], v2, s[32:35], s56 offen sc0 sc1
    s_add_u32 s56, s56, 2048
    buffer_load_dwordx2 v[18:19], v2, s[32:35], s56 offen sc0 sc1
    s_add_u32 s56, s56, 2048
    buffer_load_dwordx2 v[20:21], v2, s[32:35], s56 offen sc0 sc1
    s_add_u32 s56, s56, 2048
    buffer_load_dwordx2 v[22:23], v2, s[32:35], s56 offen sc0 sc1
    s_add_u32 s56, s56, 2048
    buffer_load_dwordx2 v[24:25], v2, s[32:35], s56 offen sc0 sc1
    s_add_u32 s56, s56, 2048
    buffer_load_dwordx2 v[26:27], v2, s[32:35], s56 offen sc0 sc1
    s_add_u32 s56, s56, 2048
    buffer_load_dwordx2 v[28:29], v2, s[32:35], s56 offen sc0 sc1
    s_add_u32 s56, s56, 2048
    buffer_load_dwordx2 v[30:31], v2, s[32:35], s56 offen sc0 sc1
    s_waitcnt vmcnt(0)
    v_max_f32 v5, v48, v50
    v_max_f32 v5, v5, v52
    v_max_f32 v5, v5, v54
    v_max_f32 v5, v5, v56
    v_max_f32 v5, v5, v58
    v_max_f32 v5, v5, v60
    v_max_f32 v5, v5, v62
    v_sub_f32 v48, v48, v5
    v_sub_f32 v50, v50, v5
    v_sub_f32 v52, v52, v5
    v_sub_f32 v54, v54, v5
    v_sub_f32 v56, v56, v5
    v_sub_f32 v58, v58, v5
    v_sub_f32 v60, v60, v5
    v_sub_f32 v62, v62, v5
    v_exp_f32 v48, v48
    v_exp_f32 v50, v50
    v_exp_f32 v52, v52
    v_exp_f32 v54, v54
    v_exp_f32 v56, v56
    v_exp_f32 v58, v58
    v_exp_f32 v60, v60
    v_exp_f32 v62, v62
    s_nop 0
    v_mul_f32 v7, v48, v49
    v_fmac_f32 v7, v50, v51
    v_fmac_f32 v7, v52, v53
    v_fmac_f32 v7, v54, v55
    v_fmac_f32 v7, v56, v57
    v_fmac_f32 v7, v58, v59
    v_fmac_f32 v7, v60, v61
    v_fmac_f32 v7, v62, v63
    v_rcp_f32 v7, v7
    v_mul_f32 v9, v48, v16
    v_mul_f32 v10, v48, v17
    v_fmac_f32 v9, v50, v18
    v_fmac_f32 v10, v50, v19
    v_fmac_f32 v9, v52, v20
    v_fmac_f32 v10, v52, v21
    v_fmac_f32 v9, v54, v22
    v_fmac_f32 v10, v54, v23
    v_fmac_f32 v9, v56, v24
    v_fmac_f32 v10, v56, v25
    v_fmac_f32 v9, v58, v26
    v_fmac_f32 v10, v58, v27
    v_fmac_f32 v9, v60, v28
    v_fmac_f32 v10, v60, v29
    v_fmac_f32 v9, v62, v30
    v_fmac_f32 v10, v62, v31

    v_mul_f32 v9, v9, v7
    v_mul_f32 v10, v10, v7
    v_cvt_pk_bf16_f32 v9, v9, v10
    s_lshl_b32 s56, s58, 2
    s_add_u32 s56, s56, s40
    s_lshl_b32 s56, s56, 8
    buffer_store_dword v9, v11, s[28:31], s56 offen
L1_end:
    s_endpgm

.section .rodata,"a"
.p2align 6
.amdhsa_kernel standalone__paged_block_table_kv_radixattention__sampling_kernel
  .amdhsa_next_free_vgpr 128
  .amdhsa_next_free_sgpr 72
  .amdhsa_accum_offset 128
  .amdhsa_group_segment_fixed_size 0
  .amdhsa_kernarg_size 64
  .amdhsa_user_sgpr_count 2
  .amdhsa_user_sgpr_kernarg_segment_ptr 1
  .amdhsa_system_sgpr_workgroup_id_x 1
.end_amdhsa_kernel
```
